```python
import torch

def _softmax(x, axis=-1):
    return torch.softmax(x, dim=axis)

def _gelu(x):
    return torch.nn.functional.gelu(x, approximate='tanh')

def _silu(x):
    return torch.nn.functional.silu(x)

def _sigmoid(x):
    return torch.sigmoid(x)

def _layernorm(x, axis=-1, eps=1e-05):
    m = x.mean(dim=axis, keepdim=True)
    v = x.var(dim=axis, keepdim=True, unbiased=False)
    return (x - m) / torch.sqrt(v + eps)

def _scatter_add(tgt, idx, src, axis=0):
    return tgt.clone().index_add_(axis, idx, src)

def _segment_sum(src, seg, n):
    out = torch.zeros((n,) + src.shape[1:], dtype=src.dtype)
    return out.index_add_(0, seg, src)

def _pad(x, pw):
    flat = tuple((v for pair in reversed(pw) for v in pair))
    return torch.nn.functional.pad(x, flat)
kernel_name = 'standalone__tree_speculative_verify_tree_attention_over_candidate_token_tree__decode'

def setup_inputs():

    _w = lambda a: (lambda t: t.to(torch.bfloat16) if t.is_floating_point() else t)(torch.as_tensor(a))
    B, Hq, Hkv, T, C, D = (4, 32, 4, 1, 8192, 128)
    tree_mask = torch.zeros((B, T, T), dtype=float)
    for b in range(B):
        parent = torch.zeros(T, dtype=torch.int64)
        for i in range(1, T):
            parent[i] = int(torch.randint(0, i, (1,)).item())
        for i in range(T):
            j = i
            tree_mask[b, i, j] = 1.0
            while j > 0:
                j = parent[j]
                tree_mask[b, i, j] = 1.0
    return {'q': _w((lambda *s: torch.randn(*s, dtype=torch.bfloat16) * 0.8)(B, Hq, T, D)), 'k_cache': _w((lambda *s: torch.randn(*s, dtype=torch.bfloat16) * 0.8)(B, Hkv, C, D)), 'v_cache': _w((lambda *s: torch.randn(*s, dtype=torch.bfloat16) * 0.05)(B, Hkv, C, D)), 'k_tree': _w((lambda *s: torch.randn(*s, dtype=torch.bfloat16) * 0.8)(B, Hkv, T, D)), 'v_tree': _w((lambda *s: torch.randn(*s, dtype=torch.bfloat16) * 0.05)(B, Hkv, T, D)), 'tree_mask': _w(tree_mask)}

def reference(q, k_cache, v_cache, k_tree, v_tree, tree_mask):
    B, Hq, T, D = q.shape
    Hkv, C = (k_cache.shape[1], k_cache.shape[2])
    rep = Hq // Hkv
    kc = (lambda x, n, axis: torch.repeat_interleave(x, n, dim=axis))(k_cache, rep, axis=1)
    vc = (lambda x, n, axis: torch.repeat_interleave(x, n, dim=axis))(v_cache, rep, axis=1)
    kt = (lambda x, n, axis: torch.repeat_interleave(x, n, dim=axis))(k_tree, rep, axis=1)
    vt = (lambda x, n, axis: torch.repeat_interleave(x, n, dim=axis))(v_tree, rep, axis=1)
    k = torch.concatenate([kc, kt], axis=2)
    v = torch.concatenate([vc, vt], axis=2)
    scale = D ** (-0.5)
    scores = torch.einsum('bhqd,bhkd->bhqk', q, k) * scale
    ctx_mask = torch.ones((B, 1, T, C), dtype=scores.dtype)
    tm = tree_mask[:, None, :, :].clone()
    full_mask = torch.concatenate([ctx_mask, tm], axis=-1)
    scores = scores + (1.0 - full_mask) * -1000000000.0
    p = _softmax(scores, axis=-1)
    return torch.einsum('bhqk,bhkd->bhqd', p, v)
```

```asm
; @launch grid=(256,1,1) block=(320,1,1) lds=150016
.amdgcn_target "amdgcn-amd-amdhsa--gfx950"
.text
.globl standalone__tree_speculative_verify_tree_attention_over_candidate_token_tree__decode_kernel
.p2align 8
.type standalone__tree_speculative_verify_tree_attention_over_candidate_token_tree__decode_kernel,@function
standalone__tree_speculative_verify_tree_attention_over_candidate_token_tree__decode_kernel:
s_load_dwordx16 s[4:19], s[0:1], 0
s_cmp_ge_u32 s2, 256
s_cbranch_scc1 L_end
v_lshrrev_b32 v2, 6, v0
v_and_b32 v1, 63, v0
v_readfirstlane_b32 s22, v2
s_and_b32 s23, s2, 15
s_lshr_b32 s24, s2, 4
s_cmp_eq_u32 s22, 4
s_cbranch_scc1 L_comm
s_lshl_b32 s25, s23, 21
s_lshl_b32 s26, s24, 17
s_add_u32 s25, s25, s26
s_lshl_b32 s26, s22, 10
s_add_u32 s25, s25, s26
s_mov_b32 m0, s26
s_lshl_b32 s44, s24, 13
s_mov_b32 s40, s44
s_mov_b32 s30, 0x20000
s_mov_b32 s31, 0x20000
s_mov_b32 s34, 0x20000
s_mov_b32 s35, 0x20000
v_lshrrev_b32 v3, 4, v1
v_and_b32 v4, 15, v1
v_xor_b32 v5, v4, v3
v_lshlrev_b32 v5, 4, v5
v_lshl_add_u32 v10, v3, 8, v5
v_xor_b32 v11, 64, v10
v_xor_b32 v12, 128, v10
v_xor_b32 v13, 192, v10
v_and_b32 v2, 3, v1
v_bfe_u32 v5, v1, 3, 1
v_lshl_add_u32 v2, v5, 2, v2
v_lshlrev_b32 v5, 4, v3
v_lshl_add_u32 v9, v2, 8, v5
s_lshl_b32 s27, s23, 11
v_add_u32 v9, s27, v9
s_waitcnt lgkmcnt(0)
s_add_u32 s28, s6, s25
s_addc_u32 s29, s7, 0
buffer_load_dwordx4 v10, s[28:31], s40 offen nt lds
s_add_u32 m0, m0, 0x1000
s_add_u32 s40, s40, 0x1000
s_and_b32 s40, s40, 0x1ffff
buffer_load_dwordx4 v11, s[28:31], s40 offen nt lds
s_add_u32 m0, m0, 0x1000
s_add_u32 s40, s40, 0x1000
s_and_b32 s40, s40, 0x1ffff
buffer_load_dwordx4 v12, s[28:31], s40 offen nt lds
s_add_u32 m0, m0, 0x1000
s_add_u32 s40, s40, 0x1000
s_and_b32 s40, s40, 0x1ffff
buffer_load_dwordx4 v13, s[28:31], s40 offen nt lds
s_add_u32 m0, m0, 0x1000
s_add_u32 s40, s40, 0x1000
s_and_b32 s40, s40, 0x1ffff
global_load_dwordx4 v[24:27], v9, s[4:5] offset:0
global_load_dwordx4 v[28:31], v9, s[4:5] offset:64
global_load_dwordx4 v[32:35], v9, s[4:5] offset:128
global_load_dwordx4 v[36:39], v9, s[4:5] offset:192
s_add_u32 s32, s8, s25
s_addc_u32 s33, s9, 0
buffer_load_dwordx4 v10, s[28:31], s40 offen nt lds
s_add_u32 m0, m0, 0x1000
s_add_u32 s40, s40, 0x1000
s_and_b32 s40, s40, 0x1ffff
buffer_load_dwordx4 v11, s[28:31], s40 offen nt lds
s_add_u32 m0, m0, 0x1000
s_add_u32 s40, s40, 0x1000
s_and_b32 s40, s40, 0x1ffff
buffer_load_dwordx4 v12, s[28:31], s40 offen nt lds
s_add_u32 m0, m0, 0x1000
s_add_u32 s40, s40, 0x1000
s_and_b32 s40, s40, 0x1ffff
buffer_load_dwordx4 v13, s[28:31], s40 offen nt lds
s_add_u32 m0, m0, 0x1000
s_add_u32 s40, s40, 0x1000
s_and_b32 s40, s40, 0x1ffff
buffer_load_dwordx4 v10, s[28:31], s40 offen nt lds
s_add_u32 m0, m0, 0x1000
s_add_u32 s40, s40, 0x1000
s_and_b32 s40, s40, 0x1ffff
buffer_load_dwordx4 v11, s[28:31], s40 offen nt lds
s_add_u32 m0, m0, 0x1000
s_add_u32 s40, s40, 0x1000
s_and_b32 s40, s40, 0x1ffff
s_load_dwordx2 s[20:21], s[0:1], 64
s_mov_b32 s41, 0x3e0293ee
v_lshlrev_b32 v5, 1, v3
v_xor_b32 v5, v5, v4
v_lshlrev_b32 v5, 4, v5
v_lshl_add_u32 v14, v3, 8, v5
v_xor_b32 v15, 128, v14
v_lshrrev_b32 v2, 2, v4
v_lshlrev_b32 v2, 12, v2
v_and_b32 v5, 3, v4
v_lshl_add_u32 v2, v5, 8, v2
v_xor_b32 v5, v3, v4
v_lshl_add_u32 v2, v5, 4, v2
s_lshl_b32 s26, s22, 10
v_add_u32 v16, s26, v2
v_xor_b32 v17, 64, v16
v_xor_b32 v18, 128, v16
v_xor_b32 v19, 192, v16
v_lshrrev_b32 v2, 2, v4
v_and_b32 v5, 1, v3
v_lshlrev_b32 v5, 2, v5
v_add_u32 v5, v5, v2
v_lshlrev_b32 v5, 1, v5
v_bfe_u32 v6, v4, 1, 1
v_xor_b32 v5, v5, v6
s_lshl_b32 s26, s22, 2
v_xor_b32 v5, s26, v5
v_lshlrev_b32 v5, 4, v5
v_lshl_add_u32 v5, v2, 8, v5
v_lshl_add_u32 v5, v3, 12, v5
v_and_b32 v6, 1, v4
v_lshl_add_u32 v20, v6, 3, v5
v_xor_b32 v21, 32, v20
s_lshr_b32 s26, s22, 1
s_lshl_b32 s26, s26, 10
s_and_b32 s27, s22, 1
s_lshl_b32 s27, s27, 3
s_add_u32 s26, s26, s27
s_add_u32 s26, s26, 131072
v_lshlrev_b32 v22, 4, v1
v_add_u32 v22, s26, v22
v_lshrrev_b32 v2, 5, v1
v_lshlrev_b32 v2, 11, v2
v_and_b32 v5, 31, v1
v_lshl_add_u32 v2, v5, 2, v2
s_lshl_b32 s26, s22, 7
v_add_u32 v23, s26, v2
s_waitcnt lgkmcnt(0)
s_mov_b32 s36, s20
s_mov_b32 s37, s21
s_mov_b32 s38, 4194304
s_mov_b32 s39, 0x20000
s_lshl_b32 s26, s23, 4
s_add_u32 s26, s26, s24
s_lshl_b32 s48, s26, 12
s_add_u32 s49, s48, 2097152
s_lshl_b32 s43, s23, 7
s_add_u32 s43, s43, 1179648
s_mov_b32 s46, 0xff
s_waitcnt vmcnt(13)
buffer_load_dwordx4 v12, s[28:31], s40 offen nt lds
s_add_u32 m0, m0, 0x1000
s_add_u32 s40, s40, 0x1000
s_and_b32 s40, s40, 0x1ffff
s_waitcnt vmcnt(13)
buffer_load_dwordx4 v13, s[28:31], s40 offen nt lds
s_add_u32 m0, m0, 0x1000
s_add_u32 s40, s40, 0x1000
s_and_b32 s40, s40, 0x1ffff
s_waitcnt vmcnt(13)
buffer_load_dwordx4 v10, s[28:31], s40 offen nt lds
s_add_u32 m0, m0, 0x1000
s_add_u32 s40, s40, 0x1000
s_and_b32 s40, s40, 0x1ffff
s_waitcnt vmcnt(13)
buffer_load_dwordx4 v11, s[28:31], s40 offen nt lds
s_add_u32 m0, m0, 0x1000
s_add_u32 s40, s40, 0x1000
s_and_b32 s40, s40, 0x1ffff
s_barrier
s_load_dword s43, s[20:21], s43
ds_read_b128 v[72:75], v16 offset:0
ds_read_b128 v[76:79], v17 offset:0
ds_read_b128 v[80:83], v18 offset:0
ds_read_b128 v[84:87], v19 offset:0
s_waitcnt vmcnt(9)
buffer_load_dwordx4 v12, s[28:31], s40 offen nt lds
s_add_u32 m0, m0, 0x1000
s_add_u32 s40, s40, 0x1000
s_and_b32 s40, s40, 0x1ffff
s_waitcnt lgkmcnt(3)
v_mfma_f32_16x16x32_bf16 v[40:43], v[72:75], v[24:27], 0
s_waitcnt lgkmcnt(2)
v_mfma_f32_16x16x32_bf16 v[40:43], v[76:79], v[28:31], v[40:43]
s_waitcnt lgkmcnt(1)
v_mfma_f32_16x16x32_bf16 v[40:43], v[80:83], v[32:35], v[40:43]
s_waitcnt lgkmcnt(0)
v_mfma_f32_16x16x32_bf16 v[40:43], v[84:87], v[36:39], v[40:43]
s_waitcnt vmcnt(9)
buffer_load_dwordx4 v13, s[28:31], s40 offen nt lds
s_add_u32 m0, m0, 0x1000
s_add_u32 s40, s40, 0x1000
s_and_b32 s40, s40, 0x1ffff
s_waitcnt vmcnt(9)
buffer_load_dwordx4 v10, s[28:31], s40 offen nt lds
s_add_u32 m0, m0, 0x1000
s_add_u32 s40, s40, 0x1000
s_and_b32 s40, s40, 0x1ffff
s_waitcnt vmcnt(9)
buffer_load_dwordx4 v11, s[28:31], s40 offen nt lds
s_add_u32 m0, m0, 0x1000
s_add_u32 s40, s40, 0x1000
s_and_b32 s40, s40, 0x1ffff
ds_read_b128 v[72:75], v16 offset:16384
ds_read_b128 v[76:79], v17 offset:16384
ds_read_b128 v[80:83], v18 offset:16384
ds_read_b128 v[84:87], v19 offset:16384
s_waitcnt vmcnt(9)
buffer_load_dwordx4 v12, s[28:31], s40 offen nt lds
s_add_u32 m0, m0, 0x1000
s_add_u32 s40, s40, 0x1000
s_and_b32 s40, s40, 0x1ffff
s_waitcnt lgkmcnt(3)
v_mfma_f32_16x16x32_bf16 v[44:47], v[72:75], v[24:27], 0
s_waitcnt lgkmcnt(2)
v_mfma_f32_16x16x32_bf16 v[44:47], v[76:79], v[28:31], v[44:47]
s_waitcnt lgkmcnt(1)
v_mfma_f32_16x16x32_bf16 v[44:47], v[80:83], v[32:35], v[44:47]
s_waitcnt lgkmcnt(0)
v_mfma_f32_16x16x32_bf16 v[44:47], v[84:87], v[36:39], v[44:47]
s_waitcnt vmcnt(9)
buffer_load_dwordx4 v13, s[28:31], s40 offen nt lds
s_add_u32 m0, m0, 0x1000
s_add_u32 s40, s40, 0x1000
s_and_b32 s40, s40, 0x1ffff
s_waitcnt vmcnt(9)
buffer_load_dwordx4 v10, s[28:31], s40 offen nt lds
s_add_u32 m0, m0, 0x1000
s_add_u32 s40, s40, 0x1000
s_and_b32 s40, s40, 0x1ffff
v_max3_f32 v6, v40, v41, v42
v_max_f32 v6, v6, v43
s_waitcnt vmcnt(9)
buffer_load_dwordx4 v11, s[28:31], s40 offen nt lds
s_add_u32 m0, m0, 0x1000
s_add_u32 s40, s40, 0x1000
s_and_b32 s40, s40, 0x1ffff
ds_read_b128 v[72:75], v16 offset:32768
ds_read_b128 v[76:79], v17 offset:32768
ds_read_b128 v[80:83], v18 offset:32768
ds_read_b128 v[84:87], v19 offset:32768
s_waitcnt vmcnt(9)
buffer_load_dwordx4 v12, s[28:31], s40 offen nt lds
s_add_u32 m0, m0, 0x1000
s_add_u32 s40, s40, 0x1000
s_and_b32 s40, s40, 0x1ffff
s_waitcnt lgkmcnt(3)
v_mfma_f32_16x16x32_bf16 v[48:51], v[72:75], v[24:27], 0
s_waitcnt lgkmcnt(2)
v_mfma_f32_16x16x32_bf16 v[48:51], v[76:79], v[28:31], v[48:51]
s_waitcnt lgkmcnt(1)
v_mfma_f32_16x16x32_bf16 v[48:51], v[80:83], v[32:35], v[48:51]
s_waitcnt lgkmcnt(0)
v_mfma_f32_16x16x32_bf16 v[48:51], v[84:87], v[36:39], v[48:51]
s_waitcnt vmcnt(9)
buffer_load_dwordx4 v13, s[28:31], s40 offen nt lds
s_add_u32 m0, m0, 0x1000
s_add_u32 s40, s40, 0x1000
s_and_b32 s40, s40, 0x1ffff
s_waitcnt vmcnt(9)
buffer_load_dwordx4 v10, s[28:31], s40 offen nt lds
s_add_u32 m0, m0, 0x1000
s_add_u32 s40, s40, 0x1000
s_and_b32 s40, s40, 0x1ffff
v_max3_f32 v6, v6, v44, v45
v_max3_f32 v6, v6, v46, v47
s_waitcnt vmcnt(9)
buffer_load_dwordx4 v11, s[28:31], s40 offen nt lds
s_add_u32 m0, m0, 0x1000
s_add_u32 s40, s40, 0x1000
s_and_b32 s40, s40, 0x1ffff
ds_read_b128 v[72:75], v16 offset:49152
ds_read_b128 v[76:79], v17 offset:49152
ds_read_b128 v[80:83], v18 offset:49152
ds_read_b128 v[84:87], v19 offset:49152
s_waitcnt vmcnt(9)
buffer_load_dwordx4 v12, s[28:31], s40 offen nt lds
s_add_u32 m0, m0, 0x1000
s_add_u32 s40, s40, 0x1000
s_and_b32 s40, s40, 0x1ffff
s_waitcnt lgkmcnt(3)
v_mfma_f32_16x16x32_bf16 v[52:55], v[72:75], v[24:27], 0
s_waitcnt lgkmcnt(2)
v_mfma_f32_16x16x32_bf16 v[52:55], v[76:79], v[28:31], v[52:55]
s_waitcnt lgkmcnt(1)
v_mfma_f32_16x16x32_bf16 v[52:55], v[80:83], v[32:35], v[52:55]
s_waitcnt lgkmcnt(0)
v_mfma_f32_16x16x32_bf16 v[52:55], v[84:87], v[36:39], v[52:55]
s_waitcnt vmcnt(9)
buffer_load_dwordx4 v13, s[28:31], s40 offen nt lds
s_add_u32 m0, m0, 0x1000
s_add_u32 s40, s40, 0x1000
s_and_b32 s40, s40, 0x1ffff
s_waitcnt vmcnt(9)
buffer_load_dwordx4 v10, s[28:31], s40 offen nt lds
s_add_u32 m0, m0, 0x1000
s_add_u32 s40, s40, 0x1000
s_and_b32 s40, s40, 0x1ffff
v_max3_f32 v6, v6, v48, v49
v_max3_f32 v6, v6, v50, v51
s_waitcnt vmcnt(9)
buffer_load_dwordx4 v11, s[28:31], s40 offen nt lds
s_add_u32 m0, m0, 0x1000
s_add_u32 s40, s40, 0x1000
s_and_b32 s40, s40, 0x1ffff
v_add_u32 v16, 0x10000, v16
v_add_u32 v17, 0x10000, v17
v_add_u32 v18, 0x10000, v18
v_add_u32 v19, 0x10000, v19
ds_read_b128 v[72:75], v16 offset:0
ds_read_b128 v[76:79], v17 offset:0
ds_read_b128 v[80:83], v18 offset:0
ds_read_b128 v[84:87], v19 offset:0
s_waitcnt vmcnt(9)
buffer_load_dwordx4 v12, s[28:31], s40 offen nt lds
s_add_u32 m0, m0, 0x1000
s_add_u32 s40, s40, 0x1000
s_and_b32 s40, s40, 0x1ffff
s_waitcnt lgkmcnt(3)
v_mfma_f32_16x16x32_bf16 v[56:59], v[72:75], v[24:27], 0
s_waitcnt lgkmcnt(2)
v_mfma_f32_16x16x32_bf16 v[56:59], v[76:79], v[28:31], v[56:59]
s_waitcnt lgkmcnt(1)
v_mfma_f32_16x16x32_bf16 v[56:59], v[80:83], v[32:35], v[56:59]
s_waitcnt lgkmcnt(0)
v_mfma_f32_16x16x32_bf16 v[56:59], v[84:87], v[36:39], v[56:59]
s_waitcnt vmcnt(9)
buffer_load_dwordx4 v13, s[28:31], s40 offen nt lds
s_waitcnt vmcnt(9)
s_mov_b32 s40, s44
s_lshl_b32 s26, s22, 10
s_mov_b32 m0, s26
s_nop 0
buffer_load_dwordx4 v14, s[32:35], s40 offen nt lds
s_add_u32 m0, m0, 0x1000
s_add_u32 s40, s40, 0x1000
s_and_b32 s40, s40, 0x1ffff
v_max3_f32 v6, v6, v52, v53
v_max3_f32 v6, v6, v54, v55
s_waitcnt vmcnt(9)
buffer_load_dwordx4 v15, s[32:35], s40 offen nt lds
s_add_u32 m0, m0, 0x1000
s_add_u32 s40, s40, 0x1000
s_and_b32 s40, s40, 0x1ffff
ds_read_b128 v[72:75], v16 offset:16384
ds_read_b128 v[76:79], v17 offset:16384
ds_read_b128 v[80:83], v18 offset:16384
ds_read_b128 v[84:87], v19 offset:16384
s_waitcnt vmcnt(9)
buffer_load_dwordx4 v14, s[32:35], s40 offen nt lds
s_add_u32 m0, m0, 0x1000
s_add_u32 s40, s40, 0x1000
s_and_b32 s40, s40, 0x1ffff
s_waitcnt lgkmcnt(3)
v_mfma_f32_16x16x32_bf16 v[60:63], v[72:75], v[24:27], 0
s_waitcnt lgkmcnt(2)
v_mfma_f32_16x16x32_bf16 v[60:63], v[76:79], v[28:31], v[60:63]
s_waitcnt lgkmcnt(1)
v_mfma_f32_16x16x32_bf16 v[60:63], v[80:83], v[32:35], v[60:63]
s_waitcnt lgkmcnt(0)
v_mfma_f32_16x16x32_bf16 v[60:63], v[84:87], v[36:39], v[60:63]
s_waitcnt vmcnt(9)
buffer_load_dwordx4 v15, s[32:35], s40 offen nt lds
s_add_u32 m0, m0, 0x1000
s_add_u32 s40, s40, 0x1000
s_and_b32 s40, s40, 0x1ffff
s_waitcnt vmcnt(9)
buffer_load_dwordx4 v14, s[32:35], s40 offen nt lds
s_add_u32 m0, m0, 0x1000
s_add_u32 s40, s40, 0x1000
s_and_b32 s40, s40, 0x1ffff
v_max3_f32 v6, v6, v56, v57
v_max3_f32 v6, v6, v58, v59
s_waitcnt vmcnt(9)
buffer_load_dwordx4 v15, s[32:35], s40 offen nt lds
s_add_u32 m0, m0, 0x1000
s_add_u32 s40, s40, 0x1000
s_and_b32 s40, s40, 0x1ffff
ds_read_b128 v[72:75], v16 offset:32768
ds_read_b128 v[76:79], v17 offset:32768
ds_read_b128 v[80:83], v18 offset:32768
ds_read_b128 v[84:87], v19 offset:32768
s_waitcnt vmcnt(9)
buffer_load_dwordx4 v14, s[32:35], s40 offen nt lds
s_add_u32 m0, m0, 0x1000
s_add_u32 s40, s40, 0x1000
s_and_b32 s40, s40, 0x1ffff
s_waitcnt lgkmcnt(3)
v_mfma_f32_16x16x32_bf16 v[64:67], v[72:75], v[24:27], 0
s_waitcnt lgkmcnt(2)
v_mfma_f32_16x16x32_bf16 v[64:67], v[76:79], v[28:31], v[64:67]
s_waitcnt lgkmcnt(1)
v_mfma_f32_16x16x32_bf16 v[64:67], v[80:83], v[32:35], v[64:67]
s_waitcnt lgkmcnt(0)
v_mfma_f32_16x16x32_bf16 v[64:67], v[84:87], v[36:39], v[64:67]
s_waitcnt vmcnt(9)
buffer_load_dwordx4 v15, s[32:35], s40 offen nt lds
s_add_u32 m0, m0, 0x1000
s_add_u32 s40, s40, 0x1000
s_and_b32 s40, s40, 0x1ffff
s_waitcnt vmcnt(9)
buffer_load_dwordx4 v14, s[32:35], s40 offen nt lds
s_add_u32 m0, m0, 0x1000
s_add_u32 s40, s40, 0x1000
s_and_b32 s40, s40, 0x1ffff
v_max3_f32 v6, v6, v60, v61
v_max3_f32 v6, v6, v62, v63
s_waitcnt vmcnt(9)
buffer_load_dwordx4 v15, s[32:35], s40 offen nt lds
s_add_u32 m0, m0, 0x1000
s_add_u32 s40, s40, 0x1000
s_and_b32 s40, s40, 0x1ffff
ds_read_b128 v[72:75], v16 offset:49152
ds_read_b128 v[76:79], v17 offset:49152
ds_read_b128 v[80:83], v18 offset:49152
ds_read_b128 v[84:87], v19 offset:49152
s_waitcnt lgkmcnt(3)
v_mfma_f32_16x16x32_bf16 v[68:71], v[72:75], v[24:27], 0
s_waitcnt lgkmcnt(2)
v_mfma_f32_16x16x32_bf16 v[68:71], v[76:79], v[28:31], v[68:71]
s_waitcnt lgkmcnt(1)
v_mfma_f32_16x16x32_bf16 v[68:71], v[80:83], v[32:35], v[68:71]
s_waitcnt lgkmcnt(0)
v_mfma_f32_16x16x32_bf16 v[68:71], v[84:87], v[36:39], v[68:71]
v_max3_f32 v6, v6, v64, v65
v_max3_f32 v6, v6, v66, v67
s_nop 5
v_max3_f32 v6, v6, v68, v69
v_max3_f32 v6, v6, v70, v71
v_mov_b32 v2, v6
s_nop 1
v_permlane32_swap_b32 v6, v2
v_max_f32 v6, v6, v2
v_mov_b32 v2, v6
s_nop 1
v_permlane16_swap_b32 v6, v2
v_max_f32 v6, v6, v2
v_lshlrev_b32 v9, 2, v1
v_add_u32 v9, 147456, v9
s_lshl_b32 s26, s22, 8
v_add_u32 v3, s26, v9
ds_write_b32 v3, v6
s_waitcnt lgkmcnt(0)
s_barrier
ds_read2st64_b32 v[4:5], v9 offset0:0 offset1:1
ds_read2st64_b32 v[6:7], v9 offset0:2 offset1:3
s_waitcnt vmcnt(9)
buffer_load_dwordx4 v14, s[32:35], s40 offen nt lds
s_add_u32 m0, m0, 0x1000
s_add_u32 s40, s40, 0x1000
s_and_b32 s40, s40, 0x1ffff
s_waitcnt lgkmcnt(0)
v_max3_f32 v6, v6, v7, v4
v_max_f32 v6, v6, v5
v_mul_f32 v6, s41, v6
v_sub_f32 v8, 0, v6
v_fma_f32 v40, v40, s41, v8
v_fma_f32 v41, v41, s41, v8
v_fma_f32 v42, v42, s41, v8
v_fma_f32 v43, v43, s41, v8
v_fma_f32 v44, v44, s41, v8
v_fma_f32 v45, v45, s41, v8
v_fma_f32 v46, v46, s41, v8
v_fma_f32 v47, v47, s41, v8
v_exp_f32 v40, v40
v_exp_f32 v41, v41
v_exp_f32 v42, v42
v_exp_f32 v43, v43
v_exp_f32 v44, v44
v_exp_f32 v45, v45
v_exp_f32 v46, v46
v_exp_f32 v47, v47
s_nop 0
v_add_f32 v7, v40, v41
v_add_f32 v7, v7, v42
v_add_f32 v7, v7, v43
v_add_f32 v7, v7, v44
v_add_f32 v7, v7, v45
v_add_f32 v7, v7, v46
v_add_f32 v7, v7, v47
v_cvt_pk_bf16_f32 v72, v40, v41
v_cvt_pk_bf16_f32 v73, v42, v43
v_cvt_pk_bf16_f32 v76, v44, v45
v_cvt_pk_bf16_f32 v77, v46, v47
ds_write_b64 v22, v[72:73] offset:0
ds_write_b64 v22, v[76:77] offset:2048
s_waitcnt vmcnt(9)
buffer_load_dwordx4 v15, s[32:35], s40 offen nt lds
s_add_u32 m0, m0, 0x1000
s_add_u32 s40, s40, 0x1000
s_and_b32 s40, s40, 0x1ffff
v_fma_f32 v48, v48, s41, v8
v_fma_f32 v49, v49, s41, v8
v_fma_f32 v50, v50, s41, v8
v_fma_f32 v51, v51, s41, v8
v_fma_f32 v52, v52, s41, v8
v_fma_f32 v53, v53, s41, v8
v_fma_f32 v54, v54, s41, v8
v_fma_f32 v55, v55, s41, v8
v_exp_f32 v48, v48
v_exp_f32 v49, v49
v_exp_f32 v50, v50
v_exp_f32 v51, v51
v_exp_f32 v52, v52
v_exp_f32 v53, v53
v_exp_f32 v54, v54
v_exp_f32 v55, v55
s_nop 0
v_add_f32 v7, v7, v48
v_add_f32 v7, v7, v49
v_add_f32 v7, v7, v50
v_add_f32 v7, v7, v51
v_add_f32 v7, v7, v52
v_add_f32 v7, v7, v53
v_add_f32 v7, v7, v54
v_add_f32 v7, v7, v55
v_cvt_pk_bf16_f32 v72, v48, v49
v_cvt_pk_bf16_f32 v73, v50, v51
v_cvt_pk_bf16_f32 v76, v52, v53
v_cvt_pk_bf16_f32 v77, v54, v55
ds_write_b64 v22, v[72:73] offset:4096
ds_write_b64 v22, v[76:77] offset:6144
s_waitcnt vmcnt(9)
buffer_load_dwordx4 v14, s[32:35], s40 offen nt lds
s_add_u32 m0, m0, 0x1000
s_add_u32 s40, s40, 0x1000
s_and_b32 s40, s40, 0x1ffff
s_waitcnt vmcnt(9)
buffer_load_dwordx4 v15, s[32:35], s40 offen nt lds
s_add_u32 m0, m0, 0x1000
s_add_u32 s40, s40, 0x1000
s_and_b32 s40, s40, 0x1ffff
v_fma_f32 v56, v56, s41, v8
v_fma_f32 v57, v57, s41, v8
v_fma_f32 v58, v58, s41, v8
v_fma_f32 v59, v59, s41, v8
v_fma_f32 v60, v60, s41, v8
v_fma_f32 v61, v61, s41, v8
v_fma_f32 v62, v62, s41, v8
v_fma_f32 v63, v63, s41, v8
v_exp_f32 v56, v56
v_exp_f32 v57, v57
v_exp_f32 v58, v58
v_exp_f32 v59, v59
v_exp_f32 v60, v60
v_exp_f32 v61, v61
v_exp_f32 v62, v62
v_exp_f32 v63, v63
s_nop 0
v_add_f32 v7, v7, v56
v_add_f32 v7, v7, v57
v_add_f32 v7, v7, v58
v_add_f32 v7, v7, v59
v_add_f32 v7, v7, v60
v_add_f32 v7, v7, v61
v_add_f32 v7, v7, v62
v_add_f32 v7, v7, v63
v_cvt_pk_bf16_f32 v72, v56, v57
v_cvt_pk_bf16_f32 v73, v58, v59
v_cvt_pk_bf16_f32 v76, v60, v61
v_cvt_pk_bf16_f32 v77, v62, v63
ds_write_b64 v22, v[72:73] offset:8192
ds_write_b64 v22, v[76:77] offset:10240
s_waitcnt vmcnt(9)
buffer_load_dwordx4 v14, s[32:35], s40 offen nt lds
s_add_u32 m0, m0, 0x1000
s_add_u32 s40, s40, 0x1000
s_and_b32 s40, s40, 0x1ffff
v_fma_f32 v64, v64, s41, v8
v_fma_f32 v65, v65, s41, v8
v_fma_f32 v66, v66, s41, v8
v_fma_f32 v67, v67, s41, v8
v_fma_f32 v68, v68, s41, v8
v_fma_f32 v69, v69, s41, v8
v_fma_f32 v70, v70, s41, v8
v_fma_f32 v71, v71, s41, v8
v_exp_f32 v64, v64
v_exp_f32 v65, v65
v_exp_f32 v66, v66
v_exp_f32 v67, v67
v_exp_f32 v68, v68
v_exp_f32 v69, v69
v_exp_f32 v70, v70
v_exp_f32 v71, v71
s_nop 0
v_add_f32 v7, v7, v64
v_add_f32 v7, v7, v65
v_add_f32 v7, v7, v66
v_add_f32 v7, v7, v67
v_add_f32 v7, v7, v68
v_add_f32 v7, v7, v69
v_add_f32 v7, v7, v70
v_add_f32 v7, v7, v71
v_cvt_pk_bf16_f32 v72, v64, v65
v_cvt_pk_bf16_f32 v73, v66, v67
v_cvt_pk_bf16_f32 v76, v68, v69
v_cvt_pk_bf16_f32 v77, v70, v71
ds_write_b64 v22, v[72:73] offset:12288
ds_write_b64 v22, v[76:77] offset:14336
s_waitcnt vmcnt(9)
buffer_load_dwordx4 v15, s[32:35], s40 offen nt lds
s_add_u32 m0, m0, 0x1000
s_add_u32 s40, s40, 0x1000
s_and_b32 s40, s40, 0x1ffff
s_waitcnt vmcnt(9)
buffer_load_dwordx4 v14, s[32:35], s40 offen nt lds
s_add_u32 m0, m0, 0x1000
s_add_u32 s40, s40, 0x1000
s_and_b32 s40, s40, 0x1ffff
v_mov_b32 v2, v7
s_nop 1
v_permlane32_swap_b32 v7, v2
v_add_f32 v7, v7, v2
v_mov_b32 v2, v7
s_nop 1
v_permlane16_swap_b32 v7, v2
v_add_f32 v7, v7, v2
ds_write_b32 v3, v7 offset:1024
ds_write_b32 v9, v6 offset:2048
s_waitcnt lgkmcnt(0)
s_barrier
v_lshlrev_b32 v2, 4, v1
v_add_u32 v2, 131072, v2
ds_read_b128 v[88:91], v2 offset:0
ds_read_b128 v[92:95], v2 offset:1024
ds_read_b128 v[96:99], v2 offset:2048
ds_read_b128 v[100:103], v2 offset:3072
ds_read_b128 v[104:107], v2 offset:4096
ds_read_b128 v[108:111], v2 offset:5120
ds_read_b128 v[112:115], v2 offset:6144
ds_read_b128 v[116:119], v2 offset:7168
ds_read_b128 v[120:123], v2 offset:8192
ds_read_b128 v[124:127], v2 offset:9216
ds_read_b128 v[128:131], v2 offset:10240
ds_read_b128 v[132:135], v2 offset:11264
ds_read_b128 v[136:139], v2 offset:12288
ds_read_b128 v[140:143], v2 offset:13312
ds_read_b128 v[144:147], v2 offset:14336
ds_read_b128 v[148:151], v2 offset:15360
s_add_u32 s43, s43, 1
v_and_b32 v3, 3, v1
v_lshlrev_b32 v4, 3, v3
v_lshrrev_b32 v9, v4, s43
v_min_u32 v3, 1, v3
v_mul_lo_u32 v3, v3, s43
v_add_u32 v9, v9, v3
v_and_b32 v3, 16, v1
v_cmp_ne_u32 vcc, 0, v3
s_waitcnt vmcnt(16)
s_waitcnt vmcnt(15)
s_waitcnt vmcnt(14)
s_waitcnt vmcnt(13)
s_barrier
ds_read_b64_tr_b16 v[152:153], v20 offset:0
ds_read_b64_tr_b16 v[154:155], v20 offset:1024
ds_read_b64_tr_b16 v[156:157], v21 offset:0
ds_read_b64_tr_b16 v[158:159], v21 offset:1024
ds_read_b64_tr_b16 v[160:161], v20 offset:2048
ds_read_b64_tr_b16 v[162:163], v20 offset:3072
ds_read_b64_tr_b16 v[164:165], v21 offset:2048
ds_read_b64_tr_b16 v[166:167], v21 offset:3072
s_waitcnt vmcnt(12)
s_waitcnt lgkmcnt(0)
v_mfma_f32_16x16x32_bf16 v[184:187], v[88:91], v[152:155], 0
v_mfma_f32_16x16x32_bf16 v[188:191], v[88:91], v[156:159], 0
v_mfma_f32_16x16x32_bf16 v[184:187], v[92:95], v[160:163], v[184:187]
v_mfma_f32_16x16x32_bf16 v[188:191], v[92:95], v[164:167], v[188:191]
s_waitcnt vmcnt(11)
s_waitcnt vmcnt(10)
s_waitcnt vmcnt(9)
buffer_load_dwordx4 v15, s[32:35], s40 offen nt lds
s_add_u32 m0, m0, 0x1000
s_add_u32 s40, s40, 0x1000
s_and_b32 s40, s40, 0x1ffff
s_barrier
ds_read_b64_tr_b16 v[168:169], v20 offset:16384
ds_read_b64_tr_b16 v[170:171], v20 offset:17408
ds_read_b64_tr_b16 v[172:173], v21 offset:16384
ds_read_b64_tr_b16 v[174:175], v21 offset:17408
ds_read_b64_tr_b16 v[176:177], v20 offset:18432
ds_read_b64_tr_b16 v[178:179], v20 offset:19456
ds_read_b64_tr_b16 v[180:181], v21 offset:18432
ds_read_b64_tr_b16 v[182:183], v21 offset:19456
s_waitcnt vmcnt(9)
buffer_load_dwordx4 v14, s[32:35], s40 offen nt lds
s_add_u32 m0, m0, 0x1000
s_add_u32 s40, s40, 0x1000
s_and_b32 s40, s40, 0x1ffff
s_waitcnt lgkmcnt(0)
v_mfma_f32_16x16x32_bf16 v[184:187], v[96:99], v[168:171], v[184:187]
v_mfma_f32_16x16x32_bf16 v[188:191], v[96:99], v[172:175], v[188:191]
v_mfma_f32_16x16x32_bf16 v[184:187], v[100:103], v[176:179], v[184:187]
v_mfma_f32_16x16x32_bf16 v[188:191], v[100:103], v[180:183], v[188:191]
s_waitcnt vmcnt(9)
buffer_load_dwordx4 v15, s[32:35], s40 offen nt lds
s_add_u32 m0, m0, 0x1000
s_add_u32 s40, s40, 0x1000
s_and_b32 s40, s40, 0x1ffff
s_waitcnt vmcnt(9)
buffer_load_dwordx4 v14, s[32:35], s40 offen nt lds
s_add_u32 m0, m0, 0x1000
s_add_u32 s40, s40, 0x1000
s_and_b32 s40, s40, 0x1ffff
s_waitcnt vmcnt(9)
buffer_load_dwordx4 v15, s[32:35], s40 offen nt lds
s_add_u32 m0, m0, 0x1000
s_add_u32 s40, s40, 0x1000
s_and_b32 s40, s40, 0x1ffff
s_barrier
ds_read_b64_tr_b16 v[152:153], v20 offset:32768
ds_read_b64_tr_b16 v[154:155], v20 offset:33792
ds_read_b64_tr_b16 v[156:157], v21 offset:32768
ds_read_b64_tr_b16 v[158:159], v21 offset:33792
ds_read_b64_tr_b16 v[160:161], v20 offset:34816
ds_read_b64_tr_b16 v[162:163], v20 offset:35840
ds_read_b64_tr_b16 v[164:165], v21 offset:34816
ds_read_b64_tr_b16 v[166:167], v21 offset:35840
s_waitcnt vmcnt(9)
buffer_load_dwordx4 v14, s[32:35], s40 offen nt lds
s_add_u32 m0, m0, 0x1000
s_add_u32 s40, s40, 0x1000
s_and_b32 s40, s40, 0x1ffff
s_waitcnt lgkmcnt(0)
v_mfma_f32_16x16x32_bf16 v[184:187], v[104:107], v[152:155], v[184:187]
v_mfma_f32_16x16x32_bf16 v[188:191], v[104:107], v[156:159], v[188:191]
v_mfma_f32_16x16x32_bf16 v[184:187], v[108:111], v[160:163], v[184:187]
v_mfma_f32_16x16x32_bf16 v[188:191], v[108:111], v[164:167], v[188:191]
s_waitcnt vmcnt(9)
buffer_load_dwordx4 v15, s[32:35], s40 offen nt lds
s_add_u32 m0, m0, 0x1000
s_add_u32 s40, s40, 0x1000
s_and_b32 s40, s40, 0x1ffff
s_waitcnt vmcnt(9)
buffer_load_dwordx4 v14, s[32:35], s40 offen nt lds
s_add_u32 m0, m0, 0x1000
s_add_u32 s40, s40, 0x1000
s_and_b32 s40, s40, 0x1ffff
s_waitcnt vmcnt(9)
buffer_load_dwordx4 v15, s[32:35], s40 offen nt lds
s_add_u32 m0, m0, 0x1000
s_add_u32 s40, s40, 0x1000
s_and_b32 s40, s40, 0x1ffff
s_barrier
ds_read_b64_tr_b16 v[168:169], v20 offset:49152
ds_read_b64_tr_b16 v[170:171], v20 offset:50176
ds_read_b64_tr_b16 v[172:173], v21 offset:49152
ds_read_b64_tr_b16 v[174:175], v21 offset:50176
ds_read_b64_tr_b16 v[176:177], v20 offset:51200
ds_read_b64_tr_b16 v[178:179], v20 offset:52224
ds_read_b64_tr_b16 v[180:181], v21 offset:51200
ds_read_b64_tr_b16 v[182:183], v21 offset:52224
s_waitcnt vmcnt(9)
buffer_load_dwordx4 v14, s[32:35], s40 offen nt lds
s_add_u32 m0, m0, 0x1000
s_add_u32 s40, s40, 0x1000
s_and_b32 s40, s40, 0x1ffff
s_waitcnt lgkmcnt(0)
v_mfma_f32_16x16x32_bf16 v[184:187], v[112:115], v[168:171], v[184:187]
v_mfma_f32_16x16x32_bf16 v[188:191], v[112:115], v[172:175], v[188:191]
v_mfma_f32_16x16x32_bf16 v[184:187], v[116:119], v[176:179], v[184:187]
v_mfma_f32_16x16x32_bf16 v[188:191], v[116:119], v[180:183], v[188:191]
s_waitcnt vmcnt(9)
buffer_load_dwordx4 v15, s[32:35], s40 offen nt lds
s_add_u32 m0, m0, 0x1000
s_add_u32 s40, s40, 0x1000
s_and_b32 s40, s40, 0x1ffff
s_waitcnt vmcnt(9)
buffer_load_dwordx4 v14, s[32:35], s40 offen nt lds
s_add_u32 m0, m0, 0x1000
s_add_u32 s40, s40, 0x1000
s_and_b32 s40, s40, 0x1ffff
s_waitcnt vmcnt(9)
buffer_load_dwordx4 v15, s[32:35], s40 offen nt lds
s_add_u32 m0, m0, 0x1000
s_add_u32 s40, s40, 0x1000
s_and_b32 s40, s40, 0x1ffff
s_barrier
v_add_u32 v20, 0x10000, v20
v_add_u32 v21, 0x10000, v21
ds_read_b64_tr_b16 v[152:153], v20 offset:0
ds_read_b64_tr_b16 v[154:155], v20 offset:1024
ds_read_b64_tr_b16 v[156:157], v21 offset:0
ds_read_b64_tr_b16 v[158:159], v21 offset:1024
ds_read_b64_tr_b16 v[160:161], v20 offset:2048
ds_read_b64_tr_b16 v[162:163], v20 offset:3072
ds_read_b64_tr_b16 v[164:165], v21 offset:2048
ds_read_b64_tr_b16 v[166:167], v21 offset:3072
s_waitcnt vmcnt(9)
buffer_load_dwordx4 v14, s[32:35], s40 offen nt lds
s_add_u32 m0, m0, 0x1000
s_add_u32 s40, s40, 0x1000
s_and_b32 s40, s40, 0x1ffff
s_waitcnt lgkmcnt(0)
v_mfma_f32_16x16x32_bf16 v[184:187], v[120:123], v[152:155], v[184:187]
v_mfma_f32_16x16x32_bf16 v[188:191], v[120:123], v[156:159], v[188:191]
v_mfma_f32_16x16x32_bf16 v[184:187], v[124:127], v[160:163], v[184:187]
v_mfma_f32_16x16x32_bf16 v[188:191], v[124:127], v[164:167], v[188:191]
s_waitcnt vmcnt(9)
buffer_load_dwordx4 v15, s[32:35], s40 offen nt lds
s_waitcnt vmcnt(9)
s_waitcnt vmcnt(8)
s_barrier
ds_read_b64_tr_b16 v[168:169], v20 offset:16384
ds_read_b64_tr_b16 v[170:171], v20 offset:17408
ds_read_b64_tr_b16 v[172:173], v21 offset:16384
ds_read_b64_tr_b16 v[174:175], v21 offset:17408
ds_read_b64_tr_b16 v[176:177], v20 offset:18432
ds_read_b64_tr_b16 v[178:179], v20 offset:19456
ds_read_b64_tr_b16 v[180:181], v21 offset:18432
ds_read_b64_tr_b16 v[182:183], v21 offset:19456
v_mov_b32 v3, 149760
ds_read_b32 v3, v3
s_waitcnt vmcnt(7)
s_waitcnt lgkmcnt(0)
v_mfma_f32_16x16x32_bf16 v[184:187], v[128:131], v[168:171], v[184:187]
v_mfma_f32_16x16x32_bf16 v[188:191], v[128:131], v[172:175], v[188:191]
v_mfma_f32_16x16x32_bf16 v[184:187], v[132:135], v[176:179], v[184:187]
v_mfma_f32_16x16x32_bf16 v[188:191], v[132:135], v[180:183], v[188:191]
v_readfirstlane_b32 s45, v3
s_waitcnt vmcnt(6)
s_waitcnt vmcnt(5)
s_waitcnt vmcnt(4)
s_barrier
ds_read_b64_tr_b16 v[152:153], v20 offset:32768
ds_read_b64_tr_b16 v[154:155], v20 offset:33792
ds_read_b64_tr_b16 v[156:157], v21 offset:32768
ds_read_b64_tr_b16 v[158:159], v21 offset:33792
ds_read_b64_tr_b16 v[160:161], v20 offset:34816
ds_read_b64_tr_b16 v[162:163], v20 offset:35840
ds_read_b64_tr_b16 v[164:165], v21 offset:34816
ds_read_b64_tr_b16 v[166:167], v21 offset:35840
s_waitcnt vmcnt(3)
s_waitcnt lgkmcnt(0)
v_mfma_f32_16x16x32_bf16 v[184:187], v[136:139], v[152:155], v[184:187]
v_mfma_f32_16x16x32_bf16 v[188:191], v[136:139], v[156:159], v[188:191]
v_mfma_f32_16x16x32_bf16 v[184:187], v[140:143], v[160:163], v[184:187]
v_mfma_f32_16x16x32_bf16 v[188:191], v[140:143], v[164:167], v[188:191]
s_waitcnt vmcnt(2)
s_waitcnt vmcnt(1)
s_waitcnt vmcnt(0)
s_barrier
ds_read_b64_tr_b16 v[168:169], v20 offset:49152
ds_read_b64_tr_b16 v[170:171], v20 offset:50176
ds_read_b64_tr_b16 v[172:173], v21 offset:49152
ds_read_b64_tr_b16 v[174:175], v21 offset:50176
ds_read_b64_tr_b16 v[176:177], v20 offset:51200
ds_read_b64_tr_b16 v[178:179], v20 offset:52224
ds_read_b64_tr_b16 v[180:181], v21 offset:51200
ds_read_b64_tr_b16 v[182:183], v21 offset:52224
s_waitcnt lgkmcnt(6)
v_mfma_f32_16x16x32_bf16 v[184:187], v[144:147], v[168:171], v[184:187]
s_waitcnt lgkmcnt(4)
v_mfma_f32_16x16x32_bf16 v[188:191], v[144:147], v[172:175], v[188:191]
s_waitcnt lgkmcnt(2)
v_mfma_f32_16x16x32_bf16 v[184:187], v[148:151], v[176:179], v[184:187]
s_waitcnt lgkmcnt(0)
v_mfma_f32_16x16x32_bf16 v[188:191], v[148:151], v[180:183], v[188:191]
s_nop 7
v_cndmask_b32 v2, v184, v188, vcc
v_cndmask_b32 v3, v185, v189, vcc
v_cndmask_b32 v4, v186, v190, vcc
v_cndmask_b32 v5, v187, v191, vcc
v_bfi_b32 v2, s46, v9, v2
buffer_store_dword v2, v23, s[36:39], s48 offen offset:0
v_bfi_b32 v3, s46, v9, v3
buffer_store_dword v3, v23, s[36:39], s48 offen offset:512
v_bfi_b32 v4, s46, v9, v4
buffer_store_dword v4, v23, s[36:39], s48 offen offset:1024
v_bfi_b32 v5, s46, v9, v5
buffer_store_dword v5, v23, s[36:39], s48 offen offset:1536
s_cmp_lg_u32 s45, 0
s_cbranch_scc1 L_skipB
buffer_store_dword v2, v23, s[36:39], s49 offen offset:0 sc1
buffer_store_dword v3, v23, s[36:39], s49 offen offset:512 sc1
buffer_store_dword v4, v23, s[36:39], s49 offen offset:1024 sc1
buffer_store_dword v5, v23, s[36:39], s49 offen offset:1536 sc1
L_skipB:
s_branch L_end
L_comm:
s_load_dwordx2 s[20:21], s[0:1], 64
v_lshrrev_b32 v56, 4, v1
v_and_b32 v55, 15, v1
v_lshl_add_u32 v60, v55, 2, v56
v_lshlrev_b32 v60, 1, v60
v_lshlrev_b32 v58, 4, v55
v_lshl_add_u32 v58, v56, 12, v58
v_lshlrev_b32 v59, 7, v56
v_lshlrev_b32 v61, 4, v1
v_lshlrev_b32 v62, 3, v1
s_lshr_b32 s42, s24, 1
s_lshl_b32 s26, s23, 3
s_add_u32 s26, s26, s42
s_lshl_b32 s26, s26, 8
v_lshl_add_u32 v4, v1, 2, s26
s_and_b32 s25, s24, 1
s_lshl_b32 s25, s25, 7
s_add_u32 s26, s26, s25
v_add_u32 v9, s26, v60
s_lshl_b32 s26, s23, 8
v_lshl_add_u32 v5, v1, 2, s26
s_add_u32 s26, s26, s25
v_add_u32 v7, s26, v60
s_lshr_b32 s26, s23, 2
s_lshl_b32 s26, s26, 1
v_mov_b32 v6, s26
v_mov_b32 v60, v9
s_lshl_b32 s26, s23, 4
s_add_u32 s26, s26, s24
s_lshl_b32 s48, s26, 12
s_lshl_b32 s26, s26, 7
s_add_u32 s56, s26, 1048576
s_add_u32 s57, s26, 1114112
s_lshl_b32 s26, s23, 11
s_add_u32 s58, s26, 1114112
s_lshl_b32 s25, s42, 4
s_add_u32 s26, s26, s25
s_add_u32 s59, s26, 1048576
s_lshl_b32 s26, s23, 16
s_lshl_b32 s25, s24, 8
s_add_u32 s52, s26, s25
s_add_u32 s53, s52, 16384
s_add_u32 s54, s52, 32768
s_add_u32 s55, s52, 49152
s_lshl_b32 s60, s23, 7
s_add_u32 s60, s60, 1179648
s_getreg_b32 s62, hwreg(HW_REG_XCC_ID, 0, 4)
s_waitcnt lgkmcnt(0)
s_mov_b32 s36, s20
s_mov_b32 s37, s21
s_mov_b32 s38, 4194304
s_mov_b32 s39, 0x20000
s_barrier
s_load_dword s43, s[20:21], s60
global_load_dword v4, v4, s[4:5]
global_load_dword v5, v5, s[10:11]
global_load_ushort v7, v7, s[12:13]
global_load_ushort v6, v6, s[14:15]
v_mov_b32 v15, 0
buffer_load_dword v15, v15, s[36:39], s56 offen
s_waitcnt lgkmcnt(0)
s_add_u32 s43, s43, 1
s_xor_b32 s47, s43, 0x5a5a5a5a
s_andn2_b32 s47, s47, 15
s_or_b32 s47, s47, s62
v_mov_b32 v10, s43
v_mov_b32 v11, s47
v_mov_b32 v70, s43
v_mov_b32 v71, s47
s_lshr_b32 s26, s43, 8
s_add_u32 s26, s26, s43
v_mov_b32 v89, s26
s_lshr_b32 s26, s43, 16
s_add_u32 s26, s26, s43
v_mov_b32 v90, s26
s_lshr_b32 s26, s43, 24
s_add_u32 s26, s26, s43
v_mov_b32 v91, s26
v_mov_b32 v88, s43
s_mov_b64 exec, 0xffff
buffer_store_dwordx2 v[10:11], v62, s[36:39], s57 offen
s_mov_b64 exec, -1
v_and_b32 v55, 3, v1
v_bfe_u32 v56, v1, 2, 1
v_lshl_add_u32 v55, v56, 3, v55
v_lshlrev_b32 v55, 2, v55
v_add_u32 v55, 148480, v55
s_barrier
s_barrier
buffer_load_dwordx2 v[16:17], v59, s[36:39], s58 offen offset:0 sc1
buffer_load_dwordx2 v[18:19], v59, s[36:39], s58 offen offset:512 sc1
buffer_load_dwordx2 v[20:21], v59, s[36:39], s58 offen offset:1024 sc1
buffer_load_dwordx2 v[22:23], v59, s[36:39], s58 offen offset:1536 sc1
ds_read2st64_b32 v[48:49], v55 offset0:0 offset1:1
ds_read2st64_b32 v[50:51], v55 offset0:2 offset1:3
ds_read_b32 v68, v55 offset:1024
s_waitcnt lgkmcnt(0)
v_add_f32 v48, v48, v49
v_add_f32 v50, v50, v51
v_add_f32 v69, v48, v50
s_mov_b64 exec, 0xff
buffer_store_dwordx4 v[68:71], v61, s[36:39], s56 offen
s_mov_b64 exec, -1
s_barrier
s_barrier
s_barrier
s_barrier
s_waitcnt vmcnt(0)
v_xor_b32 v16, v16, v10
v_xor_b32 v17, v17, v11
v_xor_b32 v18, v18, v10
v_xor_b32 v19, v19, v11
v_xor_b32 v20, v20, v10
v_xor_b32 v21, v21, v11
v_xor_b32 v22, v22, v10
v_xor_b32 v23, v23, v11
v_or3_b32 v56, v16, v17, v18
v_or3_b32 v56, v56, v19, v20
v_or3_b32 v56, v56, v21, v22
v_or_b32 v56, v56, v23
v_cmp_ne_u32 vcc, 0, v56
v_mov_b32 v55, 149760
s_cmp_eq_u64 vcc, 0
s_cselect_b32 s45, 1, 0
v_mov_b32 v56, s45
ds_write_b32 v55, v56
s_cmp_lg_u32 s45, 0
s_cbranch_scc1 L_isloc
s_add_u32 s26, s56, 2097152
s_mov_b64 exec, 0xff
buffer_store_dwordx4 v[68:71], v61, s[36:39], s26 offen sc1
s_mov_b64 exec, -1
L_isloc:
s_waitcnt lgkmcnt(0)
s_barrier
v_lshlrev_b32 v55, 16, v4
v_and_b32 v4, 0xffff0000, v4
v_lshlrev_b32 v56, 16, v5
v_and_b32 v5, 0xffff0000, v5
v_mul_f32 v8, v55, v56
v_fmac_f32 v8, v4, v5
s_nop 1
v_add_f32_dpp v8, v8, v8 quad_perm:[1,0,3,2] row_mask:0xf bank_mask:0xf
s_nop 1
v_add_f32_dpp v8, v8, v8 quad_perm:[2,3,0,1] row_mask:0xf bank_mask:0xf
s_nop 1
v_add_f32_dpp v8, v8, v8 row_half_mirror row_mask:0xf bank_mask:0xf
s_nop 1
v_add_f32_dpp v8, v8, v8 row_mirror row_mask:0xf bank_mask:0xf
v_mov_b32 v55, v8
s_nop 1
v_permlane32_swap_b32 v8, v55
v_add_f32 v8, v8, v55
v_mov_b32 v55, v8
s_nop 1
v_permlane16_swap_b32 v8, v55
v_add_f32 v8, v8, v55
s_mov_b32 s41, 0x3e0293ee
s_mov_b32 s26, 0xceabfb8f
v_lshlrev_b32 v6, 16, v6
v_sub_f32 v6, 1.0, v6
v_mul_f32 v6, s26, v6
v_fma_f32 v8, v8, s41, v6
v_lshlrev_b32 v7, 16, v7
s_barrier
v_lshlrev_b32 v13, 6, v1
buffer_load_dword v12, v13, s[36:39], s48 offen
s_barrier
buffer_load_dwordx4 v[32:35], v59, s[36:39], s59 offen offset:0 sc1
buffer_load_dwordx4 v[36:39], v59, s[36:39], s59 offen offset:512 sc1
buffer_load_dwordx4 v[40:43], v59, s[36:39], s59 offen offset:1024 sc1
buffer_load_dwordx4 v[44:47], v59, s[36:39], s59 offen offset:1536 sc1
s_barrier
s_mov_b32 s61, 200000
L_mlpoll:
buffer_load_dwordx4 v[16:19], v58, s[36:39], s52 offen sc1
buffer_load_dwordx4 v[20:23], v58, s[36:39], s53 offen sc1
buffer_load_dwordx4 v[24:27], v58, s[36:39], s54 offen sc1
buffer_load_dwordx4 v[28:31], v58, s[36:39], s55 offen sc1
s_waitcnt vmcnt(4)
v_max3_f32 v53, v32, v36, v40
v_max3_f32 v53, v53, v44, v8
v_mov_b32 v55, v53
v_xor_b32 v34, v34, v10
v_xor_b32 v38, v38, v10
v_xor_b32 v42, v42, v10
v_xor_b32 v46, v46, v10
v_permlane32_swap_b32 v53, v55
v_max_f32 v53, v53, v55
v_mov_b32 v55, v53
v_xor_b32 v35, v35, v11
v_xor_b32 v39, v39, v11
v_xor_b32 v43, v43, v11
v_xor_b32 v47, v47, v11
v_permlane16_swap_b32 v53, v55
v_max_f32 v53, v53, v55
v_or3_b32 v56, v34, v38, v42
v_or3_b32 v57, v35, v39, v43
v_or_b32 v56, v56, v46
v_or_b32 v57, v57, v47
v_and_b32 v57, -16, v57
v_or_b32 v56, v56, v57
v_cmp_ne_u32 vcc, 0, v56
v_sub_f32 v48, v32, v53
v_sub_f32 v49, v36, v53
v_sub_f32 v50, v40, v53
v_sub_f32 v51, v44, v53
v_sub_f32 v52, v8, v53
s_cmp_eq_u64 vcc, 0
s_cbranch_scc1 L_mlok
s_cmp_gt_u32 s61, 199992
s_cbranch_scc1 L_keep0
s_xor_b32 s52, s52, 2097152
s_xor_b32 s53, s53, 2097152
s_xor_b32 s54, s54, 2097152
s_xor_b32 s55, s55, 2097152
s_xor_b32 s59, s59, 2097152
L_keep0:
s_sub_u32 s61, s61, 1
s_cbranch_scc1 L_mlok
s_waitcnt vmcnt(0)
buffer_load_dwordx4 v[32:35], v59, s[36:39], s59 offen offset:0 sc1
buffer_load_dwordx4 v[36:39], v59, s[36:39], s59 offen offset:512 sc1
buffer_load_dwordx4 v[40:43], v59, s[36:39], s59 offen offset:1024 sc1
buffer_load_dwordx4 v[44:47], v59, s[36:39], s59 offen offset:1536 sc1
s_branch L_mlpoll
L_mlok:
buffer_load_dwordx4 v[72:75], v58, s[36:39], s52 offen sc1
buffer_load_dwordx4 v[76:79], v58, s[36:39], s53 offen sc1
buffer_load_dwordx4 v[80:83], v58, s[36:39], s54 offen sc1
buffer_load_dwordx4 v[84:87], v58, s[36:39], s55 offen sc1
v_exp_f32 v48, v48
v_exp_f32 v49, v49
v_exp_f32 v50, v50
v_exp_f32 v51, v51
v_exp_f32 v52, v52
s_nop 0
v_mul_f32 v54, v48, v33
v_fmac_f32 v54, v49, v37
v_fmac_f32 v54, v50, v41
v_fmac_f32 v54, v51, v45
v_mov_b32 v55, v54
s_nop 1
v_permlane32_swap_b32 v54, v55
v_add_f32 v54, v54, v55
v_mov_b32 v55, v54
s_nop 1
v_permlane16_swap_b32 v54, v55
v_add_f32 v54, v54, v55
v_add_f32 v54, v54, v52
v_rcp_f32 v54, v54
s_nop 0
v_mul_f32 v48, v48, v54
v_mul_f32 v49, v49, v54
v_mul_f32 v50, v50, v54
v_mul_f32 v51, v51, v54
v_mul_f32 v52, v52, v54
v_mul_f32 v52, v52, v7
L_poll:
s_waitcnt vmcnt(4)
v_or3_b32 v92, v16, v20, v24
v_bitop3_b32 v96, v16, v20, v24 bitop3:0x80
v_or3_b32 v93, v17, v21, v25
v_bitop3_b32 v97, v17, v21, v25 bitop3:0x80
v_or3_b32 v94, v18, v22, v26
v_bitop3_b32 v98, v18, v22, v26 bitop3:0x80
v_or3_b32 v95, v19, v23, v27
v_bitop3_b32 v99, v19, v23, v27 bitop3:0x80
v_bitop3_b32 v92, v92, v28, v88 bitop3:0x56
v_bitop3_b32 v96, v96, v28, v88 bitop3:0x6a
v_bitop3_b32 v93, v93, v29, v89 bitop3:0x56
v_bitop3_b32 v97, v97, v29, v89 bitop3:0x6a
v_bitop3_b32 v94, v94, v30, v90 bitop3:0x56
v_bitop3_b32 v98, v98, v30, v90 bitop3:0x6a
v_bitop3_b32 v95, v95, v31, v91 bitop3:0x56
v_bitop3_b32 v99, v99, v31, v91 bitop3:0x6a
v_or3_b32 v92, v92, v93, v94
v_or3_b32 v96, v96, v97, v98
v_or3_b32 v92, v92, v95, v99
v_or_b32 v92, v92, v96
v_and_b32 v92, 0xff, v92
v_cmp_ne_u32 vcc, 0, v92
v_mul_f32 v64, v48, v16
v_mul_f32 v65, v48, v17
v_mul_f32 v66, v48, v18
v_mul_f32 v67, v48, v19
s_cmp_eq_u64 vcc, 0
s_cbranch_scc1 L_doneA
buffer_load_dwordx4 v[16:19], v58, s[36:39], s52 offen sc1
buffer_load_dwordx4 v[20:23], v58, s[36:39], s53 offen sc1
buffer_load_dwordx4 v[24:27], v58, s[36:39], s54 offen sc1
buffer_load_dwordx4 v[28:31], v58, s[36:39], s55 offen sc1
s_waitcnt vmcnt(4)
v_or3_b32 v92, v72, v76, v80
v_bitop3_b32 v96, v72, v76, v80 bitop3:0x80
v_or3_b32 v93, v73, v77, v81
v_bitop3_b32 v97, v73, v77, v81 bitop3:0x80
v_or3_b32 v94, v74, v78, v82
v_bitop3_b32 v98, v74, v78, v82 bitop3:0x80
v_or3_b32 v95, v75, v79, v83
v_bitop3_b32 v99, v75, v79, v83 bitop3:0x80
v_bitop3_b32 v92, v92, v84, v88 bitop3:0x56
v_bitop3_b32 v96, v96, v84, v88 bitop3:0x6a
v_bitop3_b32 v93, v93, v85, v89 bitop3:0x56
v_bitop3_b32 v97, v97, v85, v89 bitop3:0x6a
v_bitop3_b32 v94, v94, v86, v90 bitop3:0x56
v_bitop3_b32 v98, v98, v86, v90 bitop3:0x6a
v_bitop3_b32 v95, v95, v87, v91 bitop3:0x56
v_bitop3_b32 v99, v99, v87, v91 bitop3:0x6a
v_or3_b32 v92, v92, v93, v94
v_or3_b32 v96, v96, v97, v98
v_or3_b32 v92, v92, v95, v99
v_or_b32 v92, v92, v96
v_and_b32 v92, 0xff, v92
v_cmp_ne_u32 vcc, 0, v92
v_mul_f32 v64, v48, v72
v_mul_f32 v65, v48, v73
v_mul_f32 v66, v48, v74
v_mul_f32 v67, v48, v75
s_cmp_eq_u64 vcc, 0
s_cbranch_scc1 L_doneB
s_cmp_gt_u32 s61, 199992
s_cbranch_scc1 L_keep1
s_xor_b32 s52, s52, 2097152
s_xor_b32 s53, s53, 2097152
s_xor_b32 s54, s54, 2097152
s_xor_b32 s55, s55, 2097152
s_xor_b32 s59, s59, 2097152
L_keep1:
buffer_load_dwordx4 v[72:75], v58, s[36:39], s52 offen sc1
buffer_load_dwordx4 v[76:79], v58, s[36:39], s53 offen sc1
buffer_load_dwordx4 v[80:83], v58, s[36:39], s54 offen sc1
buffer_load_dwordx4 v[84:87], v58, s[36:39], s55 offen sc1
s_sub_u32 s61, s61, 1
s_cbranch_scc0 L_poll
s_branch L_doneA
L_doneB:
v_fmac_f32 v64, v49, v76
v_fmac_f32 v65, v49, v77
v_fmac_f32 v66, v49, v78
v_fmac_f32 v67, v49, v79
v_fmac_f32 v64, v50, v80
v_fmac_f32 v65, v50, v81
v_fmac_f32 v66, v50, v82
v_fmac_f32 v67, v50, v83
v_fmac_f32 v64, v51, v84
v_fmac_f32 v65, v51, v85
v_fmac_f32 v66, v51, v86
v_fmac_f32 v67, v51, v87
s_branch L_polldone
L_doneA:
v_fmac_f32 v64, v49, v20
v_fmac_f32 v65, v49, v21
v_fmac_f32 v66, v49, v22
v_fmac_f32 v67, v49, v23
v_fmac_f32 v64, v50, v24
v_fmac_f32 v65, v50, v25
v_fmac_f32 v66, v50, v26
v_fmac_f32 v67, v50, v27
v_fmac_f32 v64, v51, v28
v_fmac_f32 v65, v51, v29
v_fmac_f32 v66, v51, v30
v_fmac_f32 v67, v51, v31
L_polldone:
s_nop 1
v_permlane32_swap_b32 v64, v66
v_permlane32_swap_b32 v65, v67
v_add_f32 v64, v64, v66
v_add_f32 v65, v65, v67
s_nop 1
v_permlane16_swap_b32 v64, v65
v_add_f32 v64, v64, v65
v_add_f32 v64, v64, v52
v_cvt_pk_bf16_f32 v64, v64, v64
global_store_short v60, v64, s[16:17]
s_cmp_lg_u32 s24, 0
s_cbranch_scc1 L_noep
v_mov_b32 v56, 0
s_mov_b64 exec, 1
buffer_store_dword v10, v56, s[36:39], s60 offen
L_noep:
L_end:
s_endpgm
.section .rodata,"a"
.p2align 6
.amdhsa_kernel standalone__tree_speculative_verify_tree_attention_over_candidate_token_tree__decode_kernel
  .amdhsa_next_free_vgpr 192
  .amdhsa_next_free_sgpr 102
  .amdhsa_accum_offset 192
  .amdhsa_group_segment_fixed_size 0
  .amdhsa_kernarg_size 72
  .amdhsa_user_sgpr_count 2
  .amdhsa_user_sgpr_kernarg_segment_ptr 1
  .amdhsa_system_sgpr_workgroup_id_x 1
  .amdhsa_float_denorm_mode_32 3
.end_amdhsa_kernel
```
